```python
import torch

def _softmax(x, axis=-1):
    return torch.softmax(x, dim=axis)
def _gelu(x):
    return torch.nn.functional.gelu(x, approximate="tanh")
def _silu(x):
    return torch.nn.functional.silu(x)
def _sigmoid(x):
    return torch.sigmoid(x)
def _layernorm(x, axis=-1, eps=1e-5):
    m = x.mean(dim=axis, keepdim=True)
    v = x.var(dim=axis, keepdim=True, unbiased=False)
    return (x - m) / torch.sqrt(v + eps)
def _scatter_add(tgt, idx, src, axis=0):
    return tgt.clone().index_add_(axis, idx, src)
def _segment_sum(src, seg, n):
    out = torch.zeros((n,) + src.shape[1:], dtype=src.dtype)
    return out.index_add_(0, seg, src)
def _pad(x, pw):
    flat = tuple(v for pair in reversed(pw) for v in pair)
    return torch.nn.functional.pad(x, flat)

kernel_name = 'standalone__softmax_full_bidir__sampling'

def setup_inputs():

    _w = (lambda a: (lambda t: t.to(torch.bfloat16) if t.is_floating_point() else t)(torch.as_tensor(a)))
    B, H, Sq, Skv, Dh = 8, 16, 4, 2048, 256
    return {
        "q": _w((lambda *s: torch.randn(*s, dtype=torch.bfloat16) * 0.8)(B, H, Sq, Dh)),
        "k": _w((lambda *s: torch.randn(*s, dtype=torch.bfloat16) * 0.8)(B, H, Skv, Dh)),
        "v": _w((lambda *s: torch.randn(*s, dtype=torch.bfloat16) * 0.05)(B, H, Skv, Dh)),
    }

def reference(q, k, v):
    scale = q.shape[-1] ** -0.5
    scores = torch.einsum('bhqd,bhkd->bhqk', q, k) * scale
    attn = _softmax(scores, axis=-1)
    return torch.einsum('bhqk,bhkd->bhqd', attn, v)
```

```asm
; @launch grid=(256,1,1) block=(320,1,1) lds=27136
.amdgcn_target "amdgcn-amd-amdhsa--gfx950"
.text
.globl standalone__softmax_full_bidir__sampling_kernel
.p2align 8
.type standalone__softmax_full_bidir__sampling_kernel,@function
standalone__softmax_full_bidir__sampling_kernel:
  s_cmp_ge_u32 s2, 256
  s_cbranch_scc1 L_end
  s_load_dwordx4 s[4:7], s[0:1], 0
  s_load_dwordx4 s[8:11], s[0:1], 16
  s_load_dwordx4 s[12:15], s[0:1], 32
  s_memrealtime s[60:61]
  v_lshrrev_b32 v1, 6, v0
  v_and_b32 v0, 63, v0
  s_and_b32 s17, s2, 127
  s_lshr_b32 s18, s2, 7
  v_readfirstlane_b32 s16, v1
  v_lshrrev_b32 v54, 4, v0
  v_bfe_u32 v55, v0, 2, 2
  v_and_b32 v56, 3, v0
  s_cmp_eq_u32 s16, 4
  s_cbranch_scc1 L_helper
  v_lshlrev_b32 v57, 6, v54
  v_lshl_add_u32 v1, v55, 9, v57
  v_lshl_add_u32 v1, v56, 4, v1
  s_lshl_b32 s39, s16, 12
  v_add_u32 v1, s39, v1
  s_lshl_b32 s42, s17, 20
  s_lshl_b32 s19, s18, 19
  s_add_u32 s42, s42, s19
  s_mov_b32 s22, 0x80000
  s_mov_b32 s23, 0x20000
  s_mov_b32 s36, 0
  s_waitcnt lgkmcnt(0)
  s_add_u32 s20, s6, s42
  s_addc_u32 s21, s7, 0
  s_and_b32 s21, s21, 0xffff
  buffer_load_dwordx4 v[64:67], v1, s[20:23], s36 offen offset:0 nt
  buffer_load_dwordx4 v[68:71], v1, s[20:23], s36 offen offset:256 nt
  v_lshl_add_u32 v58, v56, 9, v57
  v_lshl_add_u32 v58, v55, 4, v58
  s_lshl_b32 s19, s17, 11
  s_add_u32 s28, s4, s19
  s_addc_u32 s29, s5, 0
  s_and_b32 s29, s29, 0xffff
  s_mov_b32 s30, 2048
  s_mov_b32 s31, 0x20000
  buffer_load_dwordx4 v[4:7], v58, s[28:31], 0 offen
  buffer_load_dwordx4 v[8:11], v58, s[28:31], 0 offen offset:256
  buffer_load_dwordx4 v[72:75], v1, s[20:23], s36 offen offset:2048 nt
  buffer_load_dwordx4 v[76:79], v1, s[20:23], s36 offen offset:2304 nt
  s_add_u32 s36, s36, 0x4000
  buffer_load_dwordx4 v[80:83], v1, s[20:23], s36 offen offset:0 nt
  buffer_load_dwordx4 v[84:87], v1, s[20:23], s36 offen offset:256 nt
  v_and_b32 v59, 15, v0
  v_lshlrev_b32 v2, 9, v54
  v_lshl_add_u32 v2, v59, 4, v2
  v_add_u32 v2, s39, v2
  s_lshr_b32 s39, s39, 1
  v_lshlrev_b32 v3, 3, v0
  v_add_u32 v3, s39, v3
  s_add_u32 s24, s8, s42
  s_addc_u32 s25, s9, 0
  s_and_b32 s25, s25, 0xffff
  s_mov_b32 s26, 0x80000
  s_mov_b32 s27, 0x20000
  s_add_u32 s32, s10, s19
  s_addc_u32 s33, s11, 0
  s_and_b32 s33, s33, 0xffff
  s_mov_b32 s34, 2048
  s_mov_b32 s35, 0x20000
  s_xor_b32 s37, s18, 1
  s_lshl_b32 s37, s37, 8
  s_mov_b32 s40, 0x05040100
  s_mov_b32 s41, 0x07060302
  s_mov_b32 s43, 0x3db8aa3b
  s_mov_b32 s44, 0
  s_add_u32 s48, s60, 200
  s_mov_b64 vcc, 0
  s_mov_b32 s50, 0
  v_mov_b32 v128, 0
  v_mov_b32 v129, 0
  v_mov_b32 v130, 0
  v_mov_b32 v131, 0
  v_mov_b32 v132, 0
  v_mov_b32 v133, 0
  v_mov_b32 v134, 0
  v_mov_b32 v135, 0
  v_mov_b32 v136, 0
  v_mov_b32 v137, 0
  v_mov_b32 v138, 0
  v_mov_b32 v139, 0
  v_mov_b32 v140, 0
  v_mov_b32 v141, 0
  v_mov_b32 v142, 0
  v_mov_b32 v143, 0
  v_mov_b32 v144, 0
  v_mov_b32 v145, 0
  v_mov_b32 v146, 0
  v_mov_b32 v147, 0
  v_mov_b32 v148, 0
  v_mov_b32 v149, 0
  v_mov_b32 v150, 0
  v_mov_b32 v151, 0
  v_mov_b32 v152, 0
  v_mov_b32 v153, 0
  v_mov_b32 v154, 0
  v_mov_b32 v155, 0
  v_mov_b32 v156, 0
  v_mov_b32 v157, 0
  v_mov_b32 v158, 0
  v_mov_b32 v159, 0
  s_barrier
  s_mov_b32 s38, 0
L_kloop:
  s_memrealtime s[46:47]
  s_waitcnt vmcnt(5)
  s_cbranch_vccz L_w1
  s_waitcnt vmcnt(4)
L_w1:
  buffer_load_dwordx4 v[88:91], v1, s[20:23], s36 offen offset:2048 nt
  s_waitcnt vmcnt(5)
  s_cbranch_vccz L_w2
  s_waitcnt vmcnt(4)
L_w2:
  buffer_load_dwordx4 v[92:95], v1, s[20:23], s36 offen offset:2304 nt
  s_add_u32 s36, s36, 0x4000
  s_waitcnt lgkmcnt(0)
  s_sub_u32 s49, s46, s48
  s_cmp_lt_i32 s49, 0
  s_cselect_b64 vcc, -1, 0
  s_add_u32 s48, s48, 212
  v_mfma_f32_16x16x32_bf16 v[12:15], v[64:67], v[4:7], 0
  v_mfma_f32_16x16x32_bf16 v[12:15], v[68:71], v[8:11], v[12:15]
  s_nop 7
  v_add_f32_dpp v20, v13, v12 row_ror:12 row_mask:0xf bank_mask:0x1
  s_nop 1
  v_add_f32_dpp v20, v14, v20 row_ror:8 row_mask:0xf bank_mask:0x1
  s_nop 1
  v_add_f32_dpp v20, v15, v20 row_ror:4 row_mask:0xf bank_mask:0x1
  s_waitcnt vmcnt(5)
  s_cbranch_vccz L_w3
  s_waitcnt vmcnt(4)
L_w3:
  buffer_load_dwordx4 v[96:99], v1, s[20:23], s36 offen offset:0 nt
  s_waitcnt vmcnt(5)
  s_cbranch_vccz L_w4
  s_waitcnt vmcnt(4)
L_w4:
  buffer_load_dwordx4 v[100:103], v1, s[20:23], s36 offen offset:256 nt
  v_mfma_f32_16x16x32_bf16 v[12:15], v[72:75], v[4:7], 0
  v_mfma_f32_16x16x32_bf16 v[12:15], v[76:79], v[8:11], v[12:15]
  s_nop 7
  v_add_f32_dpp v21, v13, v12 row_ror:12 row_mask:0xf bank_mask:0x1
  s_nop 1
  v_add_f32_dpp v21, v14, v21 row_ror:8 row_mask:0xf bank_mask:0x1
  s_nop 1
  v_add_f32_dpp v21, v15, v21 row_ror:4 row_mask:0xf bank_mask:0x1
  s_waitcnt vmcnt(5)
  s_cbranch_vccz L_w5
  s_waitcnt vmcnt(4)
L_w5:
  buffer_load_dwordx4 v[104:107], v1, s[20:23], s36 offen offset:2048 nt
  s_waitcnt vmcnt(5)
  s_cbranch_vccz L_w6
  s_waitcnt vmcnt(4)
L_w6:
  buffer_load_dwordx4 v[108:111], v1, s[20:23], s36 offen offset:2304 nt
  s_add_u32 s36, s36, 0x4000
  v_mfma_f32_16x16x32_bf16 v[12:15], v[80:83], v[4:7], 0
  v_mfma_f32_16x16x32_bf16 v[12:15], v[84:87], v[8:11], v[12:15]
  s_nop 7
  v_add_f32_dpp v22, v13, v12 row_ror:12 row_mask:0xf bank_mask:0x1
  s_nop 1
  v_add_f32_dpp v22, v14, v22 row_ror:8 row_mask:0xf bank_mask:0x1
  s_nop 1
  v_add_f32_dpp v22, v15, v22 row_ror:4 row_mask:0xf bank_mask:0x1
  s_waitcnt vmcnt(5)
  s_cbranch_vccz L_w7
  s_waitcnt vmcnt(4)
L_w7:
  buffer_load_dwordx4 v[112:115], v1, s[20:23], s36 offen offset:0 nt
  s_waitcnt vmcnt(5)
  s_cbranch_vccz L_w8
  s_waitcnt vmcnt(4)
L_w8:
  buffer_load_dwordx4 v[116:119], v1, s[20:23], s36 offen offset:256 nt
  v_mfma_f32_16x16x32_bf16 v[12:15], v[88:91], v[4:7], 0
  v_mfma_f32_16x16x32_bf16 v[12:15], v[92:95], v[8:11], v[12:15]
  s_nop 7
  v_add_f32_dpp v23, v13, v12 row_ror:12 row_mask:0xf bank_mask:0x1
  s_nop 1
  v_add_f32_dpp v23, v14, v23 row_ror:8 row_mask:0xf bank_mask:0x1
  s_nop 1
  v_add_f32_dpp v23, v15, v23 row_ror:4 row_mask:0xf bank_mask:0x1
  s_waitcnt vmcnt(5)
  s_cbranch_vccz L_w9
  s_waitcnt vmcnt(4)
L_w9:
  buffer_load_dwordx4 v[120:123], v1, s[20:23], s36 offen offset:2048 nt
  s_waitcnt vmcnt(5)
  s_cbranch_vccz L_w10
  s_waitcnt vmcnt(4)
L_w10:
  buffer_load_dwordx4 v[124:127], v1, s[20:23], s36 offen offset:2304 nt
  s_add_u32 s36, s36, 0x4000
  v_mfma_f32_16x16x32_bf16 v[12:15], v[96:99], v[4:7], 0
  v_mfma_f32_16x16x32_bf16 v[12:15], v[100:103], v[8:11], v[12:15]
  s_nop 7
  v_add_f32_dpp v20, v12, v13 row_ror:4 row_mask:0xf bank_mask:0x2
  s_nop 1
  v_add_f32_dpp v20, v14, v20 row_ror:12 row_mask:0xf bank_mask:0x2
  s_nop 1
  v_add_f32_dpp v20, v15, v20 row_ror:8 row_mask:0xf bank_mask:0x2
  s_waitcnt vmcnt(5)
  s_cbranch_vccz L_w11
  s_waitcnt vmcnt(4)
L_w11:
  buffer_load_dwordx4 v[64:67], v1, s[20:23], s36 offen offset:0 nt
  s_waitcnt vmcnt(5)
  s_cbranch_vccz L_w12
  s_waitcnt vmcnt(4)
L_w12:
  buffer_load_dwordx4 v[68:71], v1, s[20:23], s36 offen offset:256 nt
  v_mfma_f32_16x16x32_bf16 v[12:15], v[104:107], v[4:7], 0
  v_mfma_f32_16x16x32_bf16 v[12:15], v[108:111], v[8:11], v[12:15]
  s_nop 7
  v_add_f32_dpp v21, v12, v13 row_ror:4 row_mask:0xf bank_mask:0x2
  s_nop 1
  v_add_f32_dpp v21, v14, v21 row_ror:12 row_mask:0xf bank_mask:0x2
  s_nop 1
  v_add_f32_dpp v21, v15, v21 row_ror:8 row_mask:0xf bank_mask:0x2
  s_waitcnt vmcnt(5)
  s_cbranch_vccz L_w13
  s_waitcnt vmcnt(4)
L_w13:
  buffer_load_dwordx4 v[72:75], v1, s[20:23], s36 offen offset:2048 nt
  s_waitcnt vmcnt(5)
  s_cbranch_vccz L_w14
  s_waitcnt vmcnt(4)
L_w14:
  buffer_load_dwordx4 v[76:79], v1, s[20:23], s36 offen offset:2304 nt
  s_add_u32 s36, s36, 0x4000
  v_mfma_f32_16x16x32_bf16 v[12:15], v[112:115], v[4:7], 0
  v_mfma_f32_16x16x32_bf16 v[12:15], v[116:119], v[8:11], v[12:15]
  s_nop 7
  v_add_f32_dpp v22, v12, v13 row_ror:4 row_mask:0xf bank_mask:0x2
  s_nop 1
  v_add_f32_dpp v22, v14, v22 row_ror:12 row_mask:0xf bank_mask:0x2
  s_nop 1
  v_add_f32_dpp v22, v15, v22 row_ror:8 row_mask:0xf bank_mask:0x2
  s_waitcnt vmcnt(5)
  s_cbranch_vccz L_w15
  s_waitcnt vmcnt(4)
L_w15:
  buffer_load_dwordx4 v[80:83], v1, s[20:23], s36 offen offset:0 nt
  s_waitcnt vmcnt(5)
  s_cbranch_vccz L_w16
  s_waitcnt vmcnt(4)
L_w16:
  buffer_load_dwordx4 v[84:87], v1, s[20:23], s36 offen offset:256 nt
  v_mfma_f32_16x16x32_bf16 v[12:15], v[120:123], v[4:7], 0
  v_mfma_f32_16x16x32_bf16 v[12:15], v[124:127], v[8:11], v[12:15]
  s_nop 7
  v_add_f32_dpp v23, v12, v13 row_ror:4 row_mask:0xf bank_mask:0x2
  s_nop 1
  v_add_f32_dpp v23, v14, v23 row_ror:12 row_mask:0xf bank_mask:0x2
  s_nop 1
  v_add_f32_dpp v23, v15, v23 row_ror:8 row_mask:0xf bank_mask:0x2
  s_memrealtime s[46:47]
  s_waitcnt vmcnt(5)
  s_cbranch_vccz L_w17
  s_waitcnt vmcnt(4)
L_w17:
  buffer_load_dwordx4 v[88:91], v1, s[20:23], s36 offen offset:2048 nt
  s_waitcnt vmcnt(5)
  s_cbranch_vccz L_w18
  s_waitcnt vmcnt(4)
L_w18:
  buffer_load_dwordx4 v[92:95], v1, s[20:23], s36 offen offset:2304 nt
  s_add_u32 s36, s36, 0x4000
  s_waitcnt lgkmcnt(0)
  s_sub_u32 s49, s46, s48
  s_cmp_lt_i32 s49, 0
  s_cselect_b64 vcc, -1, 0
  s_add_u32 s48, s48, 212
  v_mfma_f32_16x16x32_bf16 v[12:15], v[64:67], v[4:7], 0
  v_mfma_f32_16x16x32_bf16 v[12:15], v[68:71], v[8:11], v[12:15]
  s_nop 7
  v_add_f32_dpp v20, v12, v14 row_ror:8 row_mask:0xf bank_mask:0x4
  s_nop 1
  v_add_f32_dpp v20, v13, v20 row_ror:4 row_mask:0xf bank_mask:0x4
  s_nop 1
  v_add_f32_dpp v20, v15, v20 row_ror:12 row_mask:0xf bank_mask:0x4
  s_waitcnt vmcnt(5)
  s_cbranch_vccz L_w19
  s_waitcnt vmcnt(4)
L_w19:
  buffer_load_dwordx4 v[96:99], v1, s[20:23], s36 offen offset:0 nt
  s_waitcnt vmcnt(5)
  s_cbranch_vccz L_w20
  s_waitcnt vmcnt(4)
L_w20:
  buffer_load_dwordx4 v[100:103], v1, s[20:23], s36 offen offset:256 nt
  v_mfma_f32_16x16x32_bf16 v[12:15], v[72:75], v[4:7], 0
  v_mfma_f32_16x16x32_bf16 v[12:15], v[76:79], v[8:11], v[12:15]
  s_nop 7
  v_add_f32_dpp v21, v12, v14 row_ror:8 row_mask:0xf bank_mask:0x4
  s_nop 1
  v_add_f32_dpp v21, v13, v21 row_ror:4 row_mask:0xf bank_mask:0x4
  s_nop 1
  v_add_f32_dpp v21, v15, v21 row_ror:12 row_mask:0xf bank_mask:0x4
  s_waitcnt vmcnt(5)
  s_cbranch_vccz L_w21
  s_waitcnt vmcnt(4)
L_w21:
  buffer_load_dwordx4 v[104:107], v1, s[20:23], s36 offen offset:2048 nt
  s_waitcnt vmcnt(5)
  s_cbranch_vccz L_w22
  s_waitcnt vmcnt(4)
L_w22:
  buffer_load_dwordx4 v[108:111], v1, s[20:23], s36 offen offset:2304 nt
  s_add_u32 s36, s36, 0x4000
  v_mfma_f32_16x16x32_bf16 v[12:15], v[80:83], v[4:7], 0
  v_mfma_f32_16x16x32_bf16 v[12:15], v[84:87], v[8:11], v[12:15]
  s_nop 7
  v_add_f32_dpp v22, v12, v14 row_ror:8 row_mask:0xf bank_mask:0x4
  s_nop 1
  v_add_f32_dpp v22, v13, v22 row_ror:4 row_mask:0xf bank_mask:0x4
  s_nop 1
  v_add_f32_dpp v22, v15, v22 row_ror:12 row_mask:0xf bank_mask:0x4
  s_waitcnt vmcnt(5)
  s_cbranch_vccz L_w23
  s_waitcnt vmcnt(4)
L_w23:
  buffer_load_dwordx4 v[112:115], v1, s[20:23], s36 offen offset:0 nt
  s_waitcnt vmcnt(5)
  s_cbranch_vccz L_w24
  s_waitcnt vmcnt(4)
L_w24:
  buffer_load_dwordx4 v[116:119], v1, s[20:23], s36 offen offset:256 nt
  v_mfma_f32_16x16x32_bf16 v[12:15], v[88:91], v[4:7], 0
  v_mfma_f32_16x16x32_bf16 v[12:15], v[92:95], v[8:11], v[12:15]
  s_nop 7
  v_add_f32_dpp v23, v12, v14 row_ror:8 row_mask:0xf bank_mask:0x4
  s_nop 1
  v_add_f32_dpp v23, v13, v23 row_ror:4 row_mask:0xf bank_mask:0x4
  s_nop 1
  v_add_f32_dpp v23, v15, v23 row_ror:12 row_mask:0xf bank_mask:0x4
  s_waitcnt vmcnt(5)
  s_cbranch_vccz L_w25
  s_waitcnt vmcnt(4)
L_w25:
  buffer_load_dwordx4 v[120:123], v1, s[20:23], s36 offen offset:2048 nt
  s_waitcnt vmcnt(5)
  s_cbranch_vccz L_w26
  s_waitcnt vmcnt(4)
L_w26:
  buffer_load_dwordx4 v[124:127], v1, s[20:23], s36 offen offset:2304 nt
  s_add_u32 s36, s36, 0x4000
  v_mfma_f32_16x16x32_bf16 v[12:15], v[96:99], v[4:7], 0
  v_mfma_f32_16x16x32_bf16 v[12:15], v[100:103], v[8:11], v[12:15]
  s_nop 7
  v_add_f32_dpp v20, v12, v15 row_ror:12 row_mask:0xf bank_mask:0x8
  s_nop 1
  v_add_f32_dpp v20, v13, v20 row_ror:8 row_mask:0xf bank_mask:0x8
  s_nop 1
  v_add_f32_dpp v20, v14, v20 row_ror:4 row_mask:0xf bank_mask:0x8
  s_waitcnt vmcnt(5)
  s_cbranch_vccz L_w27
  s_waitcnt vmcnt(4)
L_w27:
  buffer_load_dwordx4 v[64:67], v1, s[20:23], s36 offen offset:0 nt
  s_waitcnt vmcnt(5)
  s_cbranch_vccz L_w28
  s_waitcnt vmcnt(4)
L_w28:
  buffer_load_dwordx4 v[68:71], v1, s[20:23], s36 offen offset:256 nt
  v_mfma_f32_16x16x32_bf16 v[12:15], v[104:107], v[4:7], 0
  v_mfma_f32_16x16x32_bf16 v[12:15], v[108:111], v[8:11], v[12:15]
  s_nop 7
  v_add_f32_dpp v21, v12, v15 row_ror:12 row_mask:0xf bank_mask:0x8
  s_nop 1
  v_add_f32_dpp v21, v13, v21 row_ror:8 row_mask:0xf bank_mask:0x8
  s_nop 1
  v_add_f32_dpp v21, v14, v21 row_ror:4 row_mask:0xf bank_mask:0x8
  s_waitcnt vmcnt(5)
  s_cbranch_vccz L_w29
  s_waitcnt vmcnt(4)
L_w29:
  buffer_load_dwordx4 v[72:75], v1, s[20:23], s36 offen offset:2048 nt
  s_waitcnt vmcnt(5)
  s_cbranch_vccz L_w30
  s_waitcnt vmcnt(4)
L_w30:
  buffer_load_dwordx4 v[76:79], v1, s[20:23], s36 offen offset:2304 nt
  s_add_u32 s36, s36, 0x4000
  v_mfma_f32_16x16x32_bf16 v[12:15], v[112:115], v[4:7], 0
  v_mfma_f32_16x16x32_bf16 v[12:15], v[116:119], v[8:11], v[12:15]
  s_nop 7
  v_add_f32_dpp v22, v12, v15 row_ror:12 row_mask:0xf bank_mask:0x8
  s_nop 1
  v_add_f32_dpp v22, v13, v22 row_ror:8 row_mask:0xf bank_mask:0x8
  s_nop 1
  v_add_f32_dpp v22, v14, v22 row_ror:4 row_mask:0xf bank_mask:0x8
  s_waitcnt vmcnt(5)
  s_cbranch_vccz L_w31
  s_waitcnt vmcnt(4)
L_w31:
  buffer_load_dwordx4 v[80:83], v1, s[20:23], s36 offen offset:0 nt
  s_waitcnt vmcnt(5)
  s_cbranch_vccz L_w32
  s_waitcnt vmcnt(4)
L_w32:
  buffer_load_dwordx4 v[84:87], v1, s[20:23], s36 offen offset:256 nt
  v_mfma_f32_16x16x32_bf16 v[12:15], v[120:123], v[4:7], 0
  v_mfma_f32_16x16x32_bf16 v[12:15], v[124:127], v[8:11], v[12:15]
  s_nop 7
  v_add_f32_dpp v23, v12, v15 row_ror:12 row_mask:0xf bank_mask:0x8
  s_nop 1
  v_add_f32_dpp v23, v13, v23 row_ror:8 row_mask:0xf bank_mask:0x8
  s_nop 1
  v_add_f32_dpp v23, v14, v23 row_ror:4 row_mask:0xf bank_mask:0x8
  v_mov_b32 v32, v28
  v_mov_b32 v33, v29
  v_mov_b32 v34, v30
  v_mov_b32 v35, v31
  v_mov_b32 v28, v24
  v_mov_b32 v29, v25
  v_mov_b32 v30, v26
  v_mov_b32 v31, v27
  v_mov_b32 v24, v20
  v_mov_b32 v25, v21
  v_mov_b32 v26, v22
  v_mov_b32 v27, v23
  s_add_u32 s38, s38, 1
  s_cmp_lt_u32 s38, 3
  s_cbranch_scc1 L_kloop
  s_memrealtime s[46:47]
  s_waitcnt vmcnt(5)
  s_cbranch_vccz L_w33
  s_waitcnt vmcnt(4)
L_w33:
  buffer_load_dwordx4 v[88:91], v1, s[20:23], s36 offen offset:2048 nt
  s_waitcnt vmcnt(5)
  s_cbranch_vccz L_w34
  s_waitcnt vmcnt(4)
L_w34:
  buffer_load_dwordx4 v[92:95], v1, s[20:23], s36 offen offset:2304 nt
  s_add_u32 s36, s36, 0x4000
  s_waitcnt lgkmcnt(0)
  s_sub_u32 s49, s46, s48
  s_cmp_lt_i32 s49, 0
  s_cselect_b64 vcc, -1, 0
  s_add_u32 s48, s48, 212
  v_mfma_f32_16x16x32_bf16 v[12:15], v[64:67], v[4:7], 0
  v_mfma_f32_16x16x32_bf16 v[12:15], v[68:71], v[8:11], v[12:15]
  s_nop 7
  v_add_f32_dpp v20, v13, v12 row_ror:12 row_mask:0xf bank_mask:0x1
  s_nop 1
  v_add_f32_dpp v20, v14, v20 row_ror:8 row_mask:0xf bank_mask:0x1
  s_nop 1
  v_add_f32_dpp v20, v15, v20 row_ror:4 row_mask:0xf bank_mask:0x1
  s_waitcnt vmcnt(5)
  s_cbranch_vccz L_w35
  s_waitcnt vmcnt(4)
L_w35:
  buffer_load_dwordx4 v[96:99], v1, s[20:23], s36 offen offset:0 nt
  s_waitcnt vmcnt(5)
  s_cbranch_vccz L_w36
  s_waitcnt vmcnt(4)
L_w36:
  buffer_load_dwordx4 v[100:103], v1, s[20:23], s36 offen offset:256 nt
  v_mfma_f32_16x16x32_bf16 v[12:15], v[72:75], v[4:7], 0
  v_mfma_f32_16x16x32_bf16 v[12:15], v[76:79], v[8:11], v[12:15]
  s_nop 7
  v_add_f32_dpp v21, v13, v12 row_ror:12 row_mask:0xf bank_mask:0x1
  s_nop 1
  v_add_f32_dpp v21, v14, v21 row_ror:8 row_mask:0xf bank_mask:0x1
  s_nop 1
  v_add_f32_dpp v21, v15, v21 row_ror:4 row_mask:0xf bank_mask:0x1
  s_waitcnt vmcnt(5)
  s_cbranch_vccz L_w37
  s_waitcnt vmcnt(4)
L_w37:
  buffer_load_dwordx4 v[104:107], v1, s[20:23], s36 offen offset:2048 nt
  s_waitcnt vmcnt(5)
  s_cbranch_vccz L_w38
  s_waitcnt vmcnt(4)
L_w38:
  buffer_load_dwordx4 v[108:111], v1, s[20:23], s36 offen offset:2304 nt
  s_add_u32 s36, s36, 0x4000
  v_mfma_f32_16x16x32_bf16 v[12:15], v[80:83], v[4:7], 0
  v_mfma_f32_16x16x32_bf16 v[12:15], v[84:87], v[8:11], v[12:15]
  s_nop 7
  v_add_f32_dpp v22, v13, v12 row_ror:12 row_mask:0xf bank_mask:0x1
  s_nop 1
  v_add_f32_dpp v22, v14, v22 row_ror:8 row_mask:0xf bank_mask:0x1
  s_nop 1
  v_add_f32_dpp v22, v15, v22 row_ror:4 row_mask:0xf bank_mask:0x1
  s_waitcnt vmcnt(5)
  s_cbranch_vccz L_w39
  s_waitcnt vmcnt(4)
L_w39:
  buffer_load_dwordx4 v[112:115], v1, s[20:23], s36 offen offset:0 nt
  s_waitcnt vmcnt(5)
  s_cbranch_vccz L_w40
  s_waitcnt vmcnt(4)
L_w40:
  buffer_load_dwordx4 v[116:119], v1, s[20:23], s36 offen offset:256 nt
  v_mfma_f32_16x16x32_bf16 v[12:15], v[88:91], v[4:7], 0
  v_mfma_f32_16x16x32_bf16 v[12:15], v[92:95], v[8:11], v[12:15]
  s_nop 7
  v_add_f32_dpp v23, v13, v12 row_ror:12 row_mask:0xf bank_mask:0x1
  s_nop 1
  v_add_f32_dpp v23, v14, v23 row_ror:8 row_mask:0xf bank_mask:0x1
  s_nop 1
  v_add_f32_dpp v23, v15, v23 row_ror:4 row_mask:0xf bank_mask:0x1
  s_waitcnt vmcnt(5)
  s_cbranch_vccz L_w41
  s_waitcnt vmcnt(4)
L_w41:
  buffer_load_dwordx4 v[120:123], v1, s[20:23], s36 offen offset:2048 nt
  s_waitcnt vmcnt(5)
  s_cbranch_vccz L_w42
  s_waitcnt vmcnt(4)
L_w42:
  buffer_load_dwordx4 v[124:127], v1, s[20:23], s36 offen offset:2304 nt
  s_add_u32 s36, s36, 0x4000
  v_mfma_f32_16x16x32_bf16 v[12:15], v[96:99], v[4:7], 0
  v_mfma_f32_16x16x32_bf16 v[12:15], v[100:103], v[8:11], v[12:15]
  s_nop 7
  v_add_f32_dpp v20, v12, v13 row_ror:4 row_mask:0xf bank_mask:0x2
  s_nop 1
  v_add_f32_dpp v20, v14, v20 row_ror:12 row_mask:0xf bank_mask:0x2
  s_nop 1
  v_add_f32_dpp v20, v15, v20 row_ror:8 row_mask:0xf bank_mask:0x2
  s_waitcnt vmcnt(5)
  s_cbranch_vccz L_w43
  s_waitcnt vmcnt(4)
L_w43:
  buffer_load_dwordx4 v[64:67], v1, s[20:23], s36 offen offset:0 nt
  s_waitcnt vmcnt(5)
  s_cbranch_vccz L_w44
  s_waitcnt vmcnt(4)
L_w44:
  buffer_load_dwordx4 v[68:71], v1, s[20:23], s36 offen offset:256 nt
  v_mfma_f32_16x16x32_bf16 v[12:15], v[104:107], v[4:7], 0
  v_mfma_f32_16x16x32_bf16 v[12:15], v[108:111], v[8:11], v[12:15]
  s_nop 7
  v_add_f32_dpp v21, v12, v13 row_ror:4 row_mask:0xf bank_mask:0x2
  s_nop 1
  v_add_f32_dpp v21, v14, v21 row_ror:12 row_mask:0xf bank_mask:0x2
  s_nop 1
  v_add_f32_dpp v21, v15, v21 row_ror:8 row_mask:0xf bank_mask:0x2
  s_waitcnt vmcnt(5)
  s_cbranch_vccz L_w45
  s_waitcnt vmcnt(4)
L_w45:
  buffer_load_dwordx4 v[72:75], v1, s[20:23], s36 offen offset:2048 nt
  s_waitcnt vmcnt(5)
  s_cbranch_vccz L_w46
  s_waitcnt vmcnt(4)
L_w46:
  buffer_load_dwordx4 v[76:79], v1, s[20:23], s36 offen offset:2304 nt
  s_add_u32 s36, s36, 0x4000
  v_mfma_f32_16x16x32_bf16 v[12:15], v[112:115], v[4:7], 0
  v_mfma_f32_16x16x32_bf16 v[12:15], v[116:119], v[8:11], v[12:15]
  s_nop 7
  v_add_f32_dpp v22, v12, v13 row_ror:4 row_mask:0xf bank_mask:0x2
  s_nop 1
  v_add_f32_dpp v22, v14, v22 row_ror:12 row_mask:0xf bank_mask:0x2
  s_nop 1
  v_add_f32_dpp v22, v15, v22 row_ror:8 row_mask:0xf bank_mask:0x2
  s_waitcnt vmcnt(5)
  s_cbranch_vccz L_w47
  s_waitcnt vmcnt(4)
L_w47:
  buffer_load_dwordx4 v[80:83], v1, s[20:23], s36 offen offset:0 nt
  s_waitcnt vmcnt(5)
  s_cbranch_vccz L_w48
  s_waitcnt vmcnt(4)
L_w48:
  buffer_load_dwordx4 v[84:87], v1, s[20:23], s36 offen offset:256 nt
  v_mfma_f32_16x16x32_bf16 v[12:15], v[120:123], v[4:7], 0
  v_mfma_f32_16x16x32_bf16 v[12:15], v[124:127], v[8:11], v[12:15]
  s_nop 7
  v_add_f32_dpp v23, v12, v13 row_ror:4 row_mask:0xf bank_mask:0x2
  s_nop 1
  v_add_f32_dpp v23, v14, v23 row_ror:12 row_mask:0xf bank_mask:0x2
  s_nop 1
  v_add_f32_dpp v23, v15, v23 row_ror:8 row_mask:0xf bank_mask:0x2
  s_memrealtime s[46:47]
  s_waitcnt vmcnt(5)
  s_cbranch_vccz L_w49
  s_waitcnt vmcnt(4)
L_w49:
  buffer_load_dwordx4 v[88:91], v1, s[20:23], s36 offen offset:2048 nt
  s_waitcnt vmcnt(5)
  s_cbranch_vccz L_w50
  s_waitcnt vmcnt(4)
L_w50:
  buffer_load_dwordx4 v[92:95], v1, s[20:23], s36 offen offset:2304 nt
  s_add_u32 s36, s36, 0x4000
  s_waitcnt lgkmcnt(0)
  s_sub_u32 s49, s46, s48
  s_cmp_lt_i32 s49, 0
  s_cselect_b64 vcc, -1, 0
  s_add_u32 s48, s48, 212
  v_mfma_f32_16x16x32_bf16 v[12:15], v[64:67], v[4:7], 0
  v_mfma_f32_16x16x32_bf16 v[12:15], v[68:71], v[8:11], v[12:15]
  s_nop 7
  v_add_f32_dpp v20, v12, v14 row_ror:8 row_mask:0xf bank_mask:0x4
  s_nop 1
  v_add_f32_dpp v20, v13, v20 row_ror:4 row_mask:0xf bank_mask:0x4
  s_nop 1
  v_add_f32_dpp v20, v15, v20 row_ror:12 row_mask:0xf bank_mask:0x4
  s_waitcnt vmcnt(5)
  s_cbranch_vccz L_w51
  s_waitcnt vmcnt(4)
L_w51:
  buffer_load_dwordx4 v[96:99], v1, s[20:23], s36 offen offset:0 nt
  s_waitcnt vmcnt(5)
  s_cbranch_vccz L_w52
  s_waitcnt vmcnt(4)
L_w52:
  buffer_load_dwordx4 v[100:103], v1, s[20:23], s36 offen offset:256 nt
  v_mfma_f32_16x16x32_bf16 v[12:15], v[72:75], v[4:7], 0
  v_mfma_f32_16x16x32_bf16 v[12:15], v[76:79], v[8:11], v[12:15]
  s_nop 7
  v_add_f32_dpp v21, v12, v14 row_ror:8 row_mask:0xf bank_mask:0x4
  s_nop 1
  v_add_f32_dpp v21, v13, v21 row_ror:4 row_mask:0xf bank_mask:0x4
  s_nop 1
  v_add_f32_dpp v21, v15, v21 row_ror:12 row_mask:0xf bank_mask:0x4
  s_waitcnt vmcnt(5)
  s_cbranch_vccz L_w53
  s_waitcnt vmcnt(4)
L_w53:
  buffer_load_dwordx4 v[104:107], v1, s[20:23], s36 offen offset:2048 nt
  s_waitcnt vmcnt(5)
  s_cbranch_vccz L_w54
  s_waitcnt vmcnt(4)
L_w54:
  buffer_load_dwordx4 v[108:111], v1, s[20:23], s36 offen offset:2304 nt
  s_add_u32 s36, s36, 0x4000
  v_mfma_f32_16x16x32_bf16 v[12:15], v[80:83], v[4:7], 0
  v_mfma_f32_16x16x32_bf16 v[12:15], v[84:87], v[8:11], v[12:15]
  s_nop 7
  v_add_f32_dpp v22, v12, v14 row_ror:8 row_mask:0xf bank_mask:0x4
  s_nop 1
  v_add_f32_dpp v22, v13, v22 row_ror:4 row_mask:0xf bank_mask:0x4
  s_nop 1
  v_add_f32_dpp v22, v15, v22 row_ror:12 row_mask:0xf bank_mask:0x4
  s_waitcnt vmcnt(5)
  s_cbranch_vccz L_w55
  s_waitcnt vmcnt(4)
L_w55:
  buffer_load_dwordx4 v[112:115], v1, s[20:23], s36 offen offset:0 nt
  s_waitcnt vmcnt(5)
  s_cbranch_vccz L_w56
  s_waitcnt vmcnt(4)
L_w56:
  buffer_load_dwordx4 v[116:119], v1, s[20:23], s36 offen offset:256 nt
  v_mfma_f32_16x16x32_bf16 v[12:15], v[88:91], v[4:7], 0
  v_mfma_f32_16x16x32_bf16 v[12:15], v[92:95], v[8:11], v[12:15]
  s_nop 7
  v_add_f32_dpp v23, v12, v14 row_ror:8 row_mask:0xf bank_mask:0x4
  s_nop 1
  v_add_f32_dpp v23, v13, v23 row_ror:4 row_mask:0xf bank_mask:0x4
  s_nop 1
  v_add_f32_dpp v23, v15, v23 row_ror:12 row_mask:0xf bank_mask:0x4
  s_waitcnt vmcnt(5)
  s_cbranch_vccz L_w57
  s_waitcnt vmcnt(4)
L_w57:
  buffer_load_dwordx4 v[120:123], v1, s[20:23], s36 offen offset:2048 nt
  s_waitcnt vmcnt(5)
  s_cbranch_vccz L_w58
  s_waitcnt vmcnt(4)
L_w58:
  buffer_load_dwordx4 v[124:127], v1, s[20:23], s36 offen offset:2304 nt
  s_add_u32 s36, s36, 0x4000
  v_mfma_f32_16x16x32_bf16 v[12:15], v[96:99], v[4:7], 0
  v_mfma_f32_16x16x32_bf16 v[12:15], v[100:103], v[8:11], v[12:15]
  s_nop 7
  v_add_f32_dpp v20, v12, v15 row_ror:12 row_mask:0xf bank_mask:0x8
  s_nop 1
  v_add_f32_dpp v20, v13, v20 row_ror:8 row_mask:0xf bank_mask:0x8
  s_nop 1
  v_add_f32_dpp v20, v14, v20 row_ror:4 row_mask:0xf bank_mask:0x8
  s_waitcnt vmcnt(5)
  s_cbranch_vccz L_w59
  s_waitcnt vmcnt(4)
L_w59:
  buffer_load_dwordx4 v[64:67], v2, s[24:27], s37 offen offset:0 nt
  s_waitcnt vmcnt(5)
  s_cbranch_vccz L_w60
  s_waitcnt vmcnt(4)
L_w60:
  buffer_load_dwordx4 v[68:71], v2, s[24:27], s37 offen offset:2048 nt
  s_add_u32 s37, s37, 0x4000
  v_mfma_f32_16x16x32_bf16 v[12:15], v[104:107], v[4:7], 0
  v_mfma_f32_16x16x32_bf16 v[12:15], v[108:111], v[8:11], v[12:15]
  s_nop 7
  v_add_f32_dpp v21, v12, v15 row_ror:12 row_mask:0xf bank_mask:0x8
  s_nop 1
  v_add_f32_dpp v21, v13, v21 row_ror:8 row_mask:0xf bank_mask:0x8
  s_nop 1
  v_add_f32_dpp v21, v14, v21 row_ror:4 row_mask:0xf bank_mask:0x8
  s_waitcnt vmcnt(5)
  s_cbranch_vccz L_w61
  s_waitcnt vmcnt(4)
L_w61:
  buffer_load_dwordx4 v[72:75], v2, s[24:27], s37 offen offset:0 nt
  s_waitcnt vmcnt(5)
  s_cbranch_vccz L_w62
  s_waitcnt vmcnt(4)
L_w62:
  buffer_load_dwordx4 v[76:79], v2, s[24:27], s37 offen offset:2048 nt
  s_add_u32 s37, s37, 0x4000
  v_mfma_f32_16x16x32_bf16 v[12:15], v[112:115], v[4:7], 0
  v_mfma_f32_16x16x32_bf16 v[12:15], v[116:119], v[8:11], v[12:15]
  s_nop 7
  v_add_f32_dpp v22, v12, v15 row_ror:12 row_mask:0xf bank_mask:0x8
  s_nop 1
  v_add_f32_dpp v22, v13, v22 row_ror:8 row_mask:0xf bank_mask:0x8
  s_nop 1
  v_add_f32_dpp v22, v14, v22 row_ror:4 row_mask:0xf bank_mask:0x8
  s_waitcnt vmcnt(5)
  s_cbranch_vccz L_w63
  s_waitcnt vmcnt(4)
L_w63:
  buffer_load_dwordx4 v[80:83], v2, s[24:27], s37 offen offset:0 nt
  s_waitcnt vmcnt(5)
  s_cbranch_vccz L_w64
  s_waitcnt vmcnt(4)
L_w64:
  buffer_load_dwordx4 v[84:87], v2, s[24:27], s37 offen offset:2048 nt
  s_add_u32 s37, s37, 0x4000
  v_mfma_f32_16x16x32_bf16 v[12:15], v[120:123], v[4:7], 0
  v_mfma_f32_16x16x32_bf16 v[12:15], v[124:127], v[8:11], v[12:15]
  s_nop 7
  v_add_f32_dpp v23, v12, v15 row_ror:12 row_mask:0xf bank_mask:0x8
  s_nop 1
  v_add_f32_dpp v23, v13, v23 row_ror:8 row_mask:0xf bank_mask:0x8
  s_nop 1
  v_add_f32_dpp v23, v14, v23 row_ror:4 row_mask:0xf bank_mask:0x8
  v_max3_f32 v54, v20, v21, v22
  v_max3_f32 v54, v54, v23, v24
  v_max3_f32 v54, v54, v25, v26
  v_max3_f32 v54, v54, v27, v28
  v_max3_f32 v54, v54, v29, v30
  v_max3_f32 v54, v54, v31, v32
  v_max3_f32 v54, v54, v33, v34
  v_max_f32 v54, v54, v35
  s_nop 1
  v_max_f32_dpp v54, v54, v54 row_ror:4 row_mask:0xf bank_mask:0xf
  s_nop 1
  v_max_f32_dpp v54, v54, v54 row_ror:8 row_mask:0xf bank_mask:0xf
  v_mov_b32 v55, v54
  s_nop 1
  v_permlane16_swap_b32 v54, v55
  s_nop 1
  v_max_f32 v54, v54, v55
  v_mov_b32 v55, v54
  s_nop 1
  v_permlane32_swap_b32 v54, v55
  s_nop 1
  v_max_f32 v54, v54, v55
  v_mul_f32 v56, s43, v54
  v_fma_f32 v20, v20, s43, -v56
  v_fma_f32 v21, v21, s43, -v56
  v_fma_f32 v22, v22, s43, -v56
  v_fma_f32 v23, v23, s43, -v56
  v_fma_f32 v24, v24, s43, -v56
  v_fma_f32 v25, v25, s43, -v56
  v_fma_f32 v26, v26, s43, -v56
  v_fma_f32 v27, v27, s43, -v56
  v_fma_f32 v28, v28, s43, -v56
  v_fma_f32 v29, v29, s43, -v56
  v_fma_f32 v30, v30, s43, -v56
  v_fma_f32 v31, v31, s43, -v56
  v_fma_f32 v32, v32, s43, -v56
  v_fma_f32 v33, v33, s43, -v56
  v_fma_f32 v34, v34, s43, -v56
  v_fma_f32 v35, v35, s43, -v56
  v_exp_f32 v20, v20
  v_exp_f32 v21, v21
  v_exp_f32 v22, v22
  v_exp_f32 v23, v23
  v_exp_f32 v24, v24
  v_exp_f32 v25, v25
  v_exp_f32 v26, v26
  v_exp_f32 v27, v27
  v_exp_f32 v28, v28
  v_exp_f32 v29, v29
  v_exp_f32 v30, v30
  v_exp_f32 v31, v31
  v_exp_f32 v32, v32
  v_exp_f32 v33, v33
  v_exp_f32 v34, v34
  v_exp_f32 v35, v35
  s_nop 0
  v_add_f32 v57, v20, v21
  v_add_f32 v57, v57, v22
  v_add_f32 v57, v57, v23
  v_add_f32 v57, v57, v24
  v_add_f32 v57, v57, v25
  v_add_f32 v57, v57, v26
  v_add_f32 v57, v57, v27
  v_add_f32 v57, v57, v28
  v_add_f32 v57, v57, v29
  v_add_f32 v57, v57, v30
  v_add_f32 v57, v57, v31
  v_add_f32 v57, v57, v32
  v_add_f32 v57, v57, v33
  v_add_f32 v57, v57, v34
  v_add_f32 v57, v57, v35
  v_cvt_pk_bf16_f32 v36, v32, v33
  v_cvt_pk_bf16_f32 v37, v34, v35
  v_cvt_pk_bf16_f32 v38, v28, v29
  v_cvt_pk_bf16_f32 v39, v30, v31
  v_cvt_pk_bf16_f32 v40, v24, v25
  v_cvt_pk_bf16_f32 v41, v26, v27
  v_cvt_pk_bf16_f32 v42, v20, v21
  v_cvt_pk_bf16_f32 v43, v22, v23
  ds_write_b64 v3, v[36:37] offset:0
  ds_write_b64 v3, v[38:39] offset:512
  ds_write_b64 v3, v[40:41] offset:1024
  ds_write_b64 v3, v[42:43] offset:1536
  s_nop 1
  v_add_f32_dpp v57, v57, v57 row_ror:4 row_mask:0xf bank_mask:0xf
  s_nop 1
  v_add_f32_dpp v57, v57, v57 row_ror:8 row_mask:0xf bank_mask:0xf
  v_mov_b32 v55, v57
  s_nop 1
  v_permlane16_swap_b32 v57, v55
  s_nop 1
  v_add_f32 v57, v57, v55
  v_mov_b32 v55, v57
  s_nop 1
  v_permlane32_swap_b32 v57, v55
  s_nop 1
  v_add_f32 v57, v57, v55
  v_and_b32 v55, 3, v0
  s_lshl_b32 s39, s16, 5
  s_add_u32 s39, s39, 26624
  v_lshl_add_u32 v55, v55, 3, s39
  ds_write_b64 v55, v[56:57]
  v_mov_b32 v55, 26880
  v_mov_b32 v54, 1
  s_waitcnt lgkmcnt(0)
  ds_add_u32 v55, v54
  s_mov_b32 s38, 0
L_vloop:
  s_cmp_eq_u32 s38, 4
  s_cbranch_scc1 L_switch
  s_cmp_eq_u32 s38, 7
  s_cbranch_scc1 L_pre
L_noswitch:
  ds_read_b64 v[52:53], v3
  v_add_u32 v3, 512, v3
  s_memrealtime s[46:47]
  s_waitcnt vmcnt(5)
  s_cbranch_vccz L_w65
  s_waitcnt vmcnt(4)
L_w65:
  buffer_load_dwordx4 v[88:91], v2, s[24:27], s37 offen offset:0 nt
  s_waitcnt vmcnt(5)
  s_cbranch_vccz L_w66
  s_waitcnt vmcnt(4)
L_w66:
  buffer_load_dwordx4 v[92:95], v2, s[24:27], s37 offen offset:2048 nt
  s_add_u32 s37, s37, 0x4000
  s_waitcnt lgkmcnt(0)
  s_sub_u32 s49, s46, s48
  s_cmp_lt_i32 s49, 0
  s_cselect_b64 vcc, -1, 0
  s_add_u32 s48, s48, 225
  v_perm_b32 v36, v68, v64, s40
  v_perm_b32 v38, v68, v64, s41
  v_perm_b32 v40, v69, v65, s40
  v_perm_b32 v42, v69, v65, s41
  v_perm_b32 v44, v70, v66, s40
  v_perm_b32 v46, v70, v66, s41
  v_perm_b32 v48, v71, v67, s40
  v_perm_b32 v50, v71, v67, s41
  s_waitcnt vmcnt(5)
  s_cbranch_vccz L_w67
  s_waitcnt vmcnt(4)
L_w67:
  buffer_load_dwordx4 v[96:99], v2, s[24:27], s37 offen offset:0 nt
  s_waitcnt vmcnt(5)
  s_cbranch_vccz L_w68
  s_waitcnt vmcnt(4)
L_w68:
  buffer_load_dwordx4 v[100:103], v2, s[24:27], s37 offen offset:2048 nt
  s_add_u32 s37, s37, 0x4000
  v_perm_b32 v37, v76, v72, s40
  v_perm_b32 v39, v76, v72, s41
  v_perm_b32 v41, v77, v73, s40
  v_perm_b32 v43, v77, v73, s41
  v_perm_b32 v45, v78, v74, s40
  v_perm_b32 v47, v78, v74, s41
  v_perm_b32 v49, v79, v75, s40
  v_perm_b32 v51, v79, v75, s41
  s_waitcnt lgkmcnt(0)
  v_mfma_f32_4x4x4_16b_bf16 v[128:131], v[52:53], v[36:37], v[128:131] cbsz:2 abid:0
  v_mfma_f32_4x4x4_16b_bf16 v[132:135], v[52:53], v[38:39], v[132:135] cbsz:2 abid:0
  v_mfma_f32_4x4x4_16b_bf16 v[136:139], v[52:53], v[40:41], v[136:139] cbsz:2 abid:0
  v_mfma_f32_4x4x4_16b_bf16 v[140:143], v[52:53], v[42:43], v[140:143] cbsz:2 abid:0
  v_mfma_f32_4x4x4_16b_bf16 v[144:147], v[52:53], v[44:45], v[144:147] cbsz:2 abid:0
  v_mfma_f32_4x4x4_16b_bf16 v[148:151], v[52:53], v[46:47], v[148:151] cbsz:2 abid:0
  v_mfma_f32_4x4x4_16b_bf16 v[152:155], v[52:53], v[48:49], v[152:155] cbsz:2 abid:0
  v_mfma_f32_4x4x4_16b_bf16 v[156:159], v[52:53], v[50:51], v[156:159] cbsz:2 abid:0
  s_waitcnt vmcnt(5)
  s_cbranch_vccz L_w69
  s_waitcnt vmcnt(4)
L_w69:
  buffer_load_dwordx4 v[104:107], v2, s[24:27], s37 offen offset:0 nt
  s_waitcnt vmcnt(5)
  s_cbranch_vccz L_w70
  s_waitcnt vmcnt(4)
L_w70:
  buffer_load_dwordx4 v[108:111], v2, s[24:27], s37 offen offset:2048 nt
  s_add_u32 s37, s37, 0x4000
  v_perm_b32 v36, v84, v80, s40
  v_perm_b32 v38, v84, v80, s41
  v_perm_b32 v40, v85, v81, s40
  v_perm_b32 v42, v85, v81, s41
  v_perm_b32 v44, v86, v82, s40
  v_perm_b32 v46, v86, v82, s41
  v_perm_b32 v48, v87, v83, s40
  v_perm_b32 v50, v87, v83, s41
  s_waitcnt vmcnt(5)
  s_cbranch_vccz L_w71
  s_waitcnt vmcnt(4)
L_w71:
  buffer_load_dwordx4 v[112:115], v2, s[24:27], s37 offen offset:0 nt
  s_waitcnt vmcnt(5)
  s_cbranch_vccz L_w72
  s_waitcnt vmcnt(4)
L_w72:
  buffer_load_dwordx4 v[116:119], v2, s[24:27], s37 offen offset:2048 nt
  s_add_u32 s37, s37, 0x4000
  v_perm_b32 v37, v92, v88, s40
  v_perm_b32 v39, v92, v88, s41
  v_perm_b32 v41, v93, v89, s40
  v_perm_b32 v43, v93, v89, s41
  v_perm_b32 v45, v94, v90, s40
  v_perm_b32 v47, v94, v90, s41
  v_perm_b32 v49, v95, v91, s40
  v_perm_b32 v51, v95, v91, s41
  v_mfma_f32_4x4x4_16b_bf16 v[128:131], v[52:53], v[36:37], v[128:131] cbsz:2 abid:1
  v_mfma_f32_4x4x4_16b_bf16 v[132:135], v[52:53], v[38:39], v[132:135] cbsz:2 abid:1
  v_mfma_f32_4x4x4_16b_bf16 v[136:139], v[52:53], v[40:41], v[136:139] cbsz:2 abid:1
  v_mfma_f32_4x4x4_16b_bf16 v[140:143], v[52:53], v[42:43], v[140:143] cbsz:2 abid:1
  v_mfma_f32_4x4x4_16b_bf16 v[144:147], v[52:53], v[44:45], v[144:147] cbsz:2 abid:1
  v_mfma_f32_4x4x4_16b_bf16 v[148:151], v[52:53], v[46:47], v[148:151] cbsz:2 abid:1
  v_mfma_f32_4x4x4_16b_bf16 v[152:155], v[52:53], v[48:49], v[152:155] cbsz:2 abid:1
  v_mfma_f32_4x4x4_16b_bf16 v[156:159], v[52:53], v[50:51], v[156:159] cbsz:2 abid:1
  s_waitcnt vmcnt(5)
  s_cbranch_vccz L_w73
  s_waitcnt vmcnt(4)
L_w73:
  buffer_load_dwordx4 v[120:123], v2, s[24:27], s37 offen offset:0 nt
  s_waitcnt vmcnt(5)
  s_cbranch_vccz L_w74
  s_waitcnt vmcnt(4)
L_w74:
  buffer_load_dwordx4 v[124:127], v2, s[24:27], s37 offen offset:2048 nt
  s_add_u32 s37, s37, 0x4000
  s_cmp_eq_u32 s38, 3
  s_cselect_b32 s39, 0x80100, 0
  s_xor_b32 s37, s37, s39
  s_cmp_eq_u32 s38, 7
  s_cselect_b32 s26, 0, s26
  v_perm_b32 v36, v100, v96, s40
  v_perm_b32 v38, v100, v96, s41
  v_perm_b32 v40, v101, v97, s40
  v_perm_b32 v42, v101, v97, s41
  v_perm_b32 v44, v102, v98, s40
  v_perm_b32 v46, v102, v98, s41
  v_perm_b32 v48, v103, v99, s40
  v_perm_b32 v50, v103, v99, s41
  s_waitcnt vmcnt(5)
  s_cbranch_vccz L_w75
  s_waitcnt vmcnt(4)
L_w75:
  buffer_load_dwordx4 v[64:67], v2, s[24:27], s37 offen offset:0 nt
  s_waitcnt vmcnt(5)
  s_cbranch_vccz L_w76
  s_waitcnt vmcnt(4)
L_w76:
  buffer_load_dwordx4 v[68:71], v2, s[24:27], s37 offen offset:2048 nt
  s_add_u32 s37, s37, 0x4000
  v_perm_b32 v37, v108, v104, s40
  v_perm_b32 v39, v108, v104, s41
  v_perm_b32 v41, v109, v105, s40
  v_perm_b32 v43, v109, v105, s41
  v_perm_b32 v45, v110, v106, s40
  v_perm_b32 v47, v110, v106, s41
  v_perm_b32 v49, v111, v107, s40
  v_perm_b32 v51, v111, v107, s41
  v_mfma_f32_4x4x4_16b_bf16 v[128:131], v[52:53], v[36:37], v[128:131] cbsz:2 abid:2
  v_mfma_f32_4x4x4_16b_bf16 v[132:135], v[52:53], v[38:39], v[132:135] cbsz:2 abid:2
  v_mfma_f32_4x4x4_16b_bf16 v[136:139], v[52:53], v[40:41], v[136:139] cbsz:2 abid:2
  v_mfma_f32_4x4x4_16b_bf16 v[140:143], v[52:53], v[42:43], v[140:143] cbsz:2 abid:2
  v_mfma_f32_4x4x4_16b_bf16 v[144:147], v[52:53], v[44:45], v[144:147] cbsz:2 abid:2
  v_mfma_f32_4x4x4_16b_bf16 v[148:151], v[52:53], v[46:47], v[148:151] cbsz:2 abid:2
  v_mfma_f32_4x4x4_16b_bf16 v[152:155], v[52:53], v[48:49], v[152:155] cbsz:2 abid:2
  v_mfma_f32_4x4x4_16b_bf16 v[156:159], v[52:53], v[50:51], v[156:159] cbsz:2 abid:2
  s_waitcnt vmcnt(5)
  s_cbranch_vccz L_w77
  s_waitcnt vmcnt(4)
L_w77:
  buffer_load_dwordx4 v[72:75], v2, s[24:27], s37 offen offset:0 nt
  s_waitcnt vmcnt(5)
  s_cbranch_vccz L_w78
  s_waitcnt vmcnt(4)
L_w78:
  buffer_load_dwordx4 v[76:79], v2, s[24:27], s37 offen offset:2048 nt
  s_add_u32 s37, s37, 0x4000
  v_perm_b32 v36, v116, v112, s40
  v_perm_b32 v38, v116, v112, s41
  v_perm_b32 v40, v117, v113, s40
  v_perm_b32 v42, v117, v113, s41
  v_perm_b32 v44, v118, v114, s40
  v_perm_b32 v46, v118, v114, s41
  v_perm_b32 v48, v119, v115, s40
  v_perm_b32 v50, v119, v115, s41
  s_waitcnt vmcnt(5)
  s_cbranch_vccz L_w79
  s_waitcnt vmcnt(4)
L_w79:
  buffer_load_dwordx4 v[80:83], v2, s[24:27], s37 offen offset:0 nt
  s_waitcnt vmcnt(5)
  s_cbranch_vccz L_w80
  s_waitcnt vmcnt(4)
L_w80:
  buffer_load_dwordx4 v[84:87], v2, s[24:27], s37 offen offset:2048 nt
  s_add_u32 s37, s37, 0x4000
  v_perm_b32 v37, v124, v120, s40
  v_perm_b32 v39, v124, v120, s41
  v_perm_b32 v41, v125, v121, s40
  v_perm_b32 v43, v125, v121, s41
  v_perm_b32 v45, v126, v122, s40
  v_perm_b32 v47, v126, v122, s41
  v_perm_b32 v49, v127, v123, s40
  v_perm_b32 v51, v127, v123, s41
  v_mfma_f32_4x4x4_16b_bf16 v[128:131], v[52:53], v[36:37], v[128:131] cbsz:2 abid:3
  v_mfma_f32_4x4x4_16b_bf16 v[132:135], v[52:53], v[38:39], v[132:135] cbsz:2 abid:3
  v_mfma_f32_4x4x4_16b_bf16 v[136:139], v[52:53], v[40:41], v[136:139] cbsz:2 abid:3
  v_mfma_f32_4x4x4_16b_bf16 v[140:143], v[52:53], v[42:43], v[140:143] cbsz:2 abid:3
  v_mfma_f32_4x4x4_16b_bf16 v[144:147], v[52:53], v[44:45], v[144:147] cbsz:2 abid:3
  v_mfma_f32_4x4x4_16b_bf16 v[148:151], v[52:53], v[46:47], v[148:151] cbsz:2 abid:3
  v_mfma_f32_4x4x4_16b_bf16 v[152:155], v[52:53], v[48:49], v[152:155] cbsz:2 abid:3
  v_mfma_f32_4x4x4_16b_bf16 v[156:159], v[52:53], v[50:51], v[156:159] cbsz:2 abid:3
  s_add_u32 s38, s38, 1
  s_cmp_lt_u32 s38, 8
  s_cbranch_scc1 L_vloop
  s_cmp_eq_u32 s44, 0
  s_cbranch_scc1 L_late
  s_nop 2
L_fin:
  v_permlane32_swap_b32 v128, v130
  v_permlane32_swap_b32 v129, v131
  v_permlane32_swap_b32 v132, v134
  v_permlane32_swap_b32 v133, v135
  v_permlane32_swap_b32 v136, v138
  v_permlane32_swap_b32 v137, v139
  v_permlane32_swap_b32 v140, v142
  v_permlane32_swap_b32 v141, v143
  v_permlane32_swap_b32 v144, v146
  v_permlane32_swap_b32 v145, v147
  v_permlane32_swap_b32 v148, v150
  v_permlane32_swap_b32 v149, v151
  v_permlane32_swap_b32 v152, v154
  v_permlane32_swap_b32 v153, v155
  v_permlane32_swap_b32 v156, v158
  v_permlane32_swap_b32 v157, v159
  v_add_f32 v128, v128, v130
  v_add_f32 v129, v129, v131
  v_add_f32 v132, v132, v134
  v_add_f32 v133, v133, v135
  v_add_f32 v136, v136, v138
  v_add_f32 v137, v137, v139
  v_add_f32 v140, v140, v142
  v_add_f32 v141, v141, v143
  v_add_f32 v144, v144, v146
  v_add_f32 v145, v145, v147
  v_add_f32 v148, v148, v150
  v_add_f32 v149, v149, v151
  v_add_f32 v152, v152, v154
  v_add_f32 v153, v153, v155
  v_add_f32 v156, v156, v158
  v_add_f32 v157, v157, v159
  s_lshl_b32 s39, s16, 11
  s_add_u32 s39, s39, 16384
  v_permlane16_swap_b32 v128, v129
  v_permlane16_swap_b32 v132, v133
  v_permlane16_swap_b32 v136, v137
  v_permlane16_swap_b32 v140, v141
  v_permlane16_swap_b32 v144, v145
  v_permlane16_swap_b32 v148, v149
  v_permlane16_swap_b32 v152, v153
  v_permlane16_swap_b32 v156, v157
  v_lshl_add_u32 v54, v0, 5, s39
  v_add_f32 v128, v128, v129
  v_add_f32 v132, v132, v133
  v_add_f32 v136, v136, v137
  v_add_f32 v140, v140, v141
  v_add_f32 v144, v144, v145
  v_add_f32 v148, v148, v149
  v_add_f32 v152, v152, v153
  v_add_f32 v156, v156, v157
  v_mul_f32 v36, v128, v62
  v_mul_f32 v37, v132, v62
  v_mul_f32 v38, v136, v62
  v_mul_f32 v39, v140, v62
  v_mul_f32 v40, v144, v62
  v_mul_f32 v41, v148, v62
  v_mul_f32 v42, v152, v62
  v_mul_f32 v43, v156, v62
  ds_write_b128 v54, v[36:39]
  ds_write_b128 v54, v[40:43] offset:16
  s_lshl_b32 s39, s16, 9
  s_add_u32 s42, s39, 16384
  v_lshl_add_u32 v54, v0, 3, s42
  s_lshl_b32 s42, s18, 8
  s_add_u32 s39, s39, s42
  v_lshl_add_u32 v55, v0, 2, s39
  s_waitcnt lgkmcnt(0)
  s_barrier
  ds_read_b64 v[36:37], v54 offset:0
  ds_read_b64 v[38:39], v54 offset:2048
  ds_read_b64 v[40:41], v54 offset:4096
  ds_read_b64 v[42:43], v54 offset:6144
  ds_read_b64 v[44:45], v54 offset:8192
  s_waitcnt lgkmcnt(3)
  v_add_f32 v36, v36, v38
  v_add_f32 v37, v37, v39
  s_waitcnt lgkmcnt(1)
  v_add_f32 v40, v40, v42
  v_add_f32 v41, v41, v43
  v_add_f32 v36, v36, v40
  v_add_f32 v37, v37, v41
  s_waitcnt lgkmcnt(0)
  v_add_f32 v36, v36, v44
  v_add_f32 v37, v37, v45
  v_cvt_pk_bf16_f32 v36, v36, v37
  buffer_store_dword v36, v55, s[32:35], 0 offen
  s_endpgm
L_late:
  v_mov_b32 v54, 26880
  s_mov_b32 s42, 0
L_wready:
  ds_read_b32 v55, v54 offset:8
  s_add_u32 s42, s42, 1
  s_waitcnt lgkmcnt(0)
  v_readfirstlane_b32 s39, v55
  s_cmp_gt_u32 s42, 2000000
  s_cbranch_scc1 L_wready_ok
  s_cmp_eq_u32 s39, 1
  s_cbranch_scc1 L_wready_ok
  s_sleep 2
  s_branch L_wready
L_wready_ok:
  v_lshrrev_b32 v54, 4, v0
  v_lshlrev_b32 v54, 2, v54
  ds_read_b32 v55, v54 offset:26752
  s_waitcnt lgkmcnt(0)
  v_mul_f32 v62, v62, v55
  s_branch L_fin
L_pre:
  v_mov_b32 v54, 26880
  ds_read_b32 v55, v54 offset:8
  s_waitcnt lgkmcnt(0)
  v_readfirstlane_b32 s44, v55
  s_nop 0
  s_cmp_eq_u32 s44, 0
  s_cbranch_scc1 L_noswitch
  v_lshrrev_b32 v54, 4, v0
  v_lshlrev_b32 v54, 2, v54
  ds_read_b32 v55, v54 offset:26752
  s_waitcnt lgkmcnt(0)
  v_mul_f32 v62, v62, v55
  s_branch L_noswitch
L_switch:
  v_mov_b32 v54, 26880
  s_mov_b32 s42, 0
L_wcnt:
  ds_read_b32 v55, v54 offset:0
  s_add_u32 s42, s42, 1
  s_waitcnt lgkmcnt(0)
  v_readfirstlane_b32 s39, v55
  s_cmp_gt_u32 s42, 2000000
  s_cbranch_scc1 L_wcnt_ok
  s_cmp_eq_u32 s39, 256
  s_cbranch_scc1 L_wcnt_ok
  s_sleep 1
  s_branch L_wcnt
L_wcnt_ok:
  v_lshrrev_b32 v54, 4, v0
  v_lshlrev_b32 v54, 3, v54
  v_add_u32 v54, 26624, v54
  ds_read_b32 v36, v54 offset:0
  ds_read_b32 v37, v54 offset:32
  ds_read_b32 v38, v54 offset:64
  ds_read_b32 v39, v54 offset:96
  s_lshl_b32 s39, s16, 5
  v_add_u32 v55, s39, v54
  ds_read_b32 v62, v55
  s_waitcnt lgkmcnt(0)
  v_max3_f32 v56, v36, v37, v38
  v_max_f32 v56, v56, v39
  v_sub_f32 v62, v62, v56
  v_exp_f32 v62, v62
  v_permlane32_swap_b32 v128, v130
  v_permlane32_swap_b32 v129, v131
  v_permlane32_swap_b32 v132, v134
  v_permlane32_swap_b32 v133, v135
  v_permlane32_swap_b32 v136, v138
  v_permlane32_swap_b32 v137, v139
  v_permlane32_swap_b32 v140, v142
  v_permlane32_swap_b32 v141, v143
  v_permlane32_swap_b32 v144, v146
  v_permlane32_swap_b32 v145, v147
  v_permlane32_swap_b32 v148, v150
  v_permlane32_swap_b32 v149, v151
  v_permlane32_swap_b32 v152, v154
  v_permlane32_swap_b32 v153, v155
  v_permlane32_swap_b32 v156, v158
  v_permlane32_swap_b32 v157, v159
  v_add_f32 v128, v128, v130
  v_add_f32 v129, v129, v131
  v_add_f32 v132, v132, v134
  v_add_f32 v133, v133, v135
  v_add_f32 v136, v136, v138
  v_add_f32 v137, v137, v139
  v_add_f32 v140, v140, v142
  v_add_f32 v141, v141, v143
  v_add_f32 v144, v144, v146
  v_add_f32 v145, v145, v147
  v_add_f32 v148, v148, v150
  v_add_f32 v149, v149, v151
  v_add_f32 v152, v152, v154
  v_add_f32 v153, v153, v155
  v_add_f32 v156, v156, v158
  v_add_f32 v157, v157, v159
  s_lshl_b32 s39, s16, 11
  s_add_u32 s39, s39, 8192
  v_permlane16_swap_b32 v128, v129
  v_permlane16_swap_b32 v132, v133
  v_permlane16_swap_b32 v136, v137
  v_permlane16_swap_b32 v140, v141
  v_permlane16_swap_b32 v144, v145
  v_permlane16_swap_b32 v148, v149
  v_permlane16_swap_b32 v152, v153
  v_permlane16_swap_b32 v156, v157
  v_lshl_add_u32 v54, v0, 5, s39
  v_add_f32 v128, v128, v129
  v_add_f32 v132, v132, v133
  v_add_f32 v136, v136, v137
  v_add_f32 v140, v140, v141
  v_add_f32 v144, v144, v145
  v_add_f32 v148, v148, v149
  v_add_f32 v152, v152, v153
  v_add_f32 v156, v156, v157
  v_mul_f32 v36, v128, v62
  v_mul_f32 v37, v132, v62
  v_mul_f32 v38, v136, v62
  v_mul_f32 v39, v140, v62
  v_mul_f32 v40, v144, v62
  v_mul_f32 v41, v148, v62
  v_mul_f32 v42, v152, v62
  v_mul_f32 v43, v156, v62
  ds_write_b128 v54, v[36:39]
  ds_write_b128 v54, v[40:43] offset:16
  v_mov_b32 v55, 26880
  v_mov_b32 v56, 1
  s_waitcnt lgkmcnt(0)
  ds_add_u32 v55, v56 offset:4
  v_mov_b32 v128, 0
  v_mov_b32 v129, 0
  v_mov_b32 v130, 0
  v_mov_b32 v131, 0
  v_mov_b32 v132, 0
  v_mov_b32 v133, 0
  v_mov_b32 v134, 0
  v_mov_b32 v135, 0
  v_mov_b32 v136, 0
  v_mov_b32 v137, 0
  v_mov_b32 v138, 0
  v_mov_b32 v139, 0
  v_mov_b32 v140, 0
  v_mov_b32 v141, 0
  v_mov_b32 v142, 0
  v_mov_b32 v143, 0
  v_mov_b32 v144, 0
  v_mov_b32 v145, 0
  v_mov_b32 v146, 0
  v_mov_b32 v147, 0
  v_mov_b32 v148, 0
  v_mov_b32 v149, 0
  v_mov_b32 v150, 0
  v_mov_b32 v151, 0
  v_mov_b32 v152, 0
  v_mov_b32 v153, 0
  v_mov_b32 v154, 0
  v_mov_b32 v155, 0
  v_mov_b32 v156, 0
  v_mov_b32 v157, 0
  v_mov_b32 v158, 0
  v_mov_b32 v159, 0
  v_subrev_u32 v3, 2048, v3
  s_branch L_noswitch
L_helper:
  v_mov_b32 v1, 26880
  v_mov_b32 v2, 0
  v_mov_b32 v3, 0
  v_mov_b32 v4, 0
  v_mov_b32 v5, 0
  ds_write_b128 v1, v[2:5]
  s_getreg_b32 s45, hwreg(HW_REG_XCC_ID)
  s_and_b32 s45, s45, 15
  s_waitcnt lgkmcnt(0)
  v_lshlrev_b32 v4, 4, v0
  s_lshl_b32 s39, s2, 12
  s_add_u32 s24, s14, s39
  s_addc_u32 s25, s15, 0
  s_and_b32 s25, s25, 0xffff
  s_mov_b32 s26, 4096
  s_mov_b32 s27, 0x20000
  s_xor_b32 s40, s2, 128
  s_lshl_b32 s39, s40, 12
  s_add_u32 s20, s14, s39
  s_addc_u32 s21, s15, 0
  s_and_b32 s21, s21, 0xffff
  s_mov_b32 s22, 4096
  s_mov_b32 s23, 0x20000
  v_mov_b32 v5, 3200
  buffer_load_dword v6, v5, s[24:27], 0 offen sc1
  buffer_load_dword v7, v5, s[20:23], 0 offen sc1
  s_barrier
  s_waitcnt vmcnt(0)
  v_readfirstlane_b32 s58, v6
  v_readfirstlane_b32 s59, v7
  s_nop 1
  s_mul_i32 s52, s58, 0x9e3779b1
  s_mul_i32 s53, s59, 0x9e3779b1
  s_add_u32 s74, s52, 0x85ebca6b
  s_add_u32 s75, s53, 0x85ebca6b
  s_add_u32 s76, s52, 0x27d4eb2f
  s_add_u32 s77, s53, 0x27d4eb2f
  v_mov_b32 v8, s76
  v_mov_b32 v9, s45
  v_mov_b32 v5, 3072
  s_mov_b64 exec, 1
  buffer_store_dwordx2 v[8:9], v5, s[24:27], 0 offen
  s_mov_b64 exec, -1
  s_mov_b32 s44, 0
L_h_wait1:
  ds_read_b32 v2, v1 offset:4
  s_add_u32 s44, s44, 1
  s_waitcnt lgkmcnt(0)
  v_readfirstlane_b32 s39, v2
  s_cmp_gt_u32 s44, 2000000
  s_cbranch_scc1 L_h_go1
  s_cmp_eq_u32 s39, 256
  s_cbranch_scc1 L_h_go1
  s_sleep 16
  s_branch L_h_wait1
L_h_go1:
  v_mov_b32 v5, 3072
  buffer_load_dwordx2 v[58:59], v5, s[20:23], 0 offen sc1
  ds_read_b128 v[8:11], v4 offset:8192
  ds_read_b128 v[12:15], v4 offset:9216
  ds_read_b128 v[16:19], v4 offset:10240
  ds_read_b128 v[20:23], v4 offset:11264
  ds_read_b128 v[24:27], v4 offset:12288
  ds_read_b128 v[28:31], v4 offset:13312
  ds_read_b128 v[32:35], v4 offset:14336
  ds_read_b128 v[36:39], v4 offset:15360
  v_and_b32 v5, 3, v0
  v_lshlrev_b32 v5, 3, v5
  ds_read_b64 v[40:41], v5 offset:26624
  ds_read_b64 v[42:43], v5 offset:26656
  ds_read_b64 v[44:45], v5 offset:26688
  ds_read_b64 v[46:47], v5 offset:26720
  s_waitcnt lgkmcnt(0)
  v_add_f32 v8, v8, v16
  v_add_f32 v24, v24, v32
  v_add_f32 v9, v9, v17
  v_add_f32 v25, v25, v33
  v_add_f32 v10, v10, v18
  v_add_f32 v26, v26, v34
  v_add_f32 v11, v11, v19
  v_add_f32 v27, v27, v35
  v_add_f32 v12, v12, v20
  v_add_f32 v28, v28, v36
  v_add_f32 v13, v13, v21
  v_add_f32 v29, v29, v37
  v_add_f32 v14, v14, v22
  v_add_f32 v30, v30, v38
  v_add_f32 v15, v15, v23
  v_add_f32 v31, v31, v39
  v_add_f32 v8, v8, v24
  v_add_f32 v9, v9, v25
  v_add_f32 v10, v10, v26
  v_add_f32 v11, v11, v27
  v_add_f32 v12, v12, v28
  v_add_f32 v13, v13, v29
  v_add_f32 v14, v14, v30
  v_add_f32 v15, v15, v31
  v_max3_f32 v48, v40, v42, v44
  v_max_f32 v48, v48, v46
  v_sub_f32 v40, v40, v48
  v_sub_f32 v42, v42, v48
  v_sub_f32 v44, v44, v48
  v_sub_f32 v46, v46, v48
  v_exp_f32 v40, v40
  v_exp_f32 v42, v42
  v_exp_f32 v44, v44
  v_exp_f32 v46, v46
  s_nop 0
  v_mul_f32 v49, v40, v41
  v_fmac_f32 v49, v42, v43
  v_fmac_f32 v49, v44, v45
  v_fmac_f32 v49, v46, v47
  v_and_b32 v6, 4, v0
  v_cmp_eq_u32 vcc, 0, v6
  v_mov_b32 v19, s74
  v_mov_b32 v16, v8
  v_mov_b32 v17, v9
  v_mov_b32 v18, v10
  v_mov_b32 v20, v11
  v_mov_b32 v21, v12
  v_mov_b32 v22, v13
  v_mov_b32 v23, v19
  v_mov_b32 v24, v14
  v_mov_b32 v25, v15
  v_cndmask_b32 v26, v49, v48, vcc
  v_mov_b32 v27, v19
  s_waitcnt vmcnt(0)
  v_readfirstlane_b32 s46, v58
  v_readfirstlane_b32 s47, v59
  s_nop 1
  s_cmp_eq_u32 s46, s77
  s_cselect_b32 s47, s47, 0xffff
  s_cmp_eq_u32 s45, s47
  s_cbranch_scc1 L_h_same
  buffer_store_dwordx4 v[16:19], v4, s[24:27], 0 offen offset:0 sc1
  buffer_store_dwordx4 v[20:23], v4, s[24:27], 0 offen offset:1024 sc1
  buffer_store_dwordx4 v[24:27], v4, s[24:27], 0 offen offset:2048 sc1
  s_branch L_h_pub
L_h_same:
  buffer_store_dwordx4 v[16:19], v4, s[24:27], 0 offen offset:0
  buffer_store_dwordx4 v[20:23], v4, s[24:27], 0 offen offset:1024
  buffer_store_dwordx4 v[24:27], v4, s[24:27], 0 offen offset:2048
L_h_pub:
  s_mov_b32 s44, 0
  s_sleep 16
L_h_wait2:
  buffer_load_dwordx4 v[8:11], v4, s[20:23], 0 offen offset:0 sc1
  buffer_load_dwordx4 v[12:15], v4, s[20:23], 0 offen offset:1024 sc1
  buffer_load_dwordx4 v[16:19], v4, s[20:23], 0 offen offset:2048 sc1
  s_add_u32 s44, s44, 1
  v_mov_b32 v20, s75
  s_waitcnt vmcnt(0)
  v_cmp_eq_u32 s[48:49], v11, v20
  v_cmp_eq_u32 s[50:51], v15, v20
  v_cmp_eq_u32 vcc, v19, v20
  s_cmp_gt_u32 s44, 2000000
  s_cbranch_scc1 L_h_go2
  s_and_b64 s[48:49], s[48:49], s[50:51]
  s_and_b64 s[48:49], s[48:49], vcc
  s_cmp_eq_u64 s[48:49], -1
  s_cbranch_scc1 L_h_go2
  s_sleep 16
  s_branch L_h_wait2
L_h_go2:
  s_add_u32 s59, s59, 1
  v_mov_b32 v5, 3200
  v_mov_b32 v6, s59
  s_mov_b64 exec, 1
  buffer_store_dword v6, v5, s[20:23], 0 offen
  s_mov_b64 exec, 0xff
  v_lshlrev_b32 v6, 2, v0
  ds_write_b32 v6, v18 offset:26784
  s_mov_b64 exec, -1
  v_and_b32 v6, 3, v0
  v_lshlrev_b32 v6, 2, v6
  s_waitcnt lgkmcnt(0)
  ds_read_b32 v50, v6 offset:26784
  ds_read_b32 v51, v6 offset:26800
  s_waitcnt lgkmcnt(0)
  v_max_f32 v52, v48, v50
  v_sub_f32 v53, v48, v52
  v_sub_f32 v54, v50, v52
  v_exp_f32 v53, v53
  v_exp_f32 v54, v54
  s_nop 0
  v_mul_f32 v55, v49, v53
  v_fmac_f32 v55, v51, v54
  v_rcp_f32 v55, v55
  s_nop 0
  v_mul_f32 v53, v53, v55
  v_mul_f32 v54, v54, v55
  ds_write_b32 v6, v53 offset:26752
  ds_write_b32 v6, v54 offset:26768
  v_lshrrev_b32 v6, 5, v0
  v_lshlrev_b32 v6, 2, v6
  s_waitcnt lgkmcnt(0)
  ds_read_b32 v56, v6 offset:26768
  ds_read_b32 v57, v6 offset:26776
  s_waitcnt lgkmcnt(0)
  v_mul_f32 v20, v8, v56
  v_mul_f32 v21, v9, v56
  v_mul_f32 v22, v10, v56
  v_mul_f32 v23, v12, v56
  v_mul_f32 v24, v13, v57
  v_mul_f32 v25, v14, v57
  v_mul_f32 v26, v16, v57
  v_mul_f32 v27, v17, v57
  ds_write_b128 v4, v[20:23] offset:24576
  ds_write_b128 v4, v[24:27] offset:25600
  v_mov_b32 v2, 1
  s_waitcnt lgkmcnt(0)
  ds_write_b32 v1, v2 offset:8
  s_waitcnt lgkmcnt(0)
  s_barrier
L_end:
  s_endpgm
.section .rodata,"a"
.p2align 6
.amdhsa_kernel standalone__softmax_full_bidir__sampling_kernel
  .amdhsa_next_free_vgpr 160
  .amdhsa_next_free_sgpr 80
  .amdhsa_accum_offset 160
  .amdhsa_group_segment_fixed_size 0
  .amdhsa_kernarg_size 48
  .amdhsa_user_sgpr_count 2
  .amdhsa_user_sgpr_kernarg_segment_ptr 1
  .amdhsa_system_sgpr_workgroup_id_x 1
.end_amdhsa_kernel
```
